```python
import torch

def _softmax(x, axis=-1):
    return torch.softmax(x, dim=axis)
def _gelu(x):
    return torch.nn.functional.gelu(x, approximate="tanh")
def _silu(x):
    return torch.nn.functional.silu(x)
def _sigmoid(x):
    return torch.sigmoid(x)
def _layernorm(x, axis=-1, eps=1e-5):
    m = x.mean(dim=axis, keepdim=True)
    v = x.var(dim=axis, keepdim=True, unbiased=False)
    return (x - m) / torch.sqrt(v + eps)
def _scatter_add(tgt, idx, src, axis=0):
    return tgt.clone().index_add_(axis, idx, src)
def _segment_sum(src, seg, n):
    out = torch.zeros((n,) + src.shape[1:], dtype=src.dtype)
    return out.index_add_(0, seg, src)
def _pad(x, pw):
    flat = tuple(v for pair in reversed(pw) for v in pair)
    return torch.nn.functional.pad(x, flat)

kernel_name = 'standalone__gqa_softmax__sampling'

def setup_inputs():

    _w = (lambda a: (lambda t: t.to(torch.bfloat16) if t.is_floating_point() else t)(torch.as_tensor(a)))
    B, Hq, Hkv, Sq, Sk, D = 16, 32, 16, 8, 4096, 128
    return {
        "q": _w((lambda *s: torch.randn(*s, dtype=torch.bfloat16) * 0.8)(B, Hq, Sq, D)),
        "k": _w((lambda *s: torch.randn(*s, dtype=torch.bfloat16) * 0.8)(B, Hkv, Sk, D)),
        "v": _w((lambda *s: torch.randn(*s, dtype=torch.bfloat16) * 0.05)(B, Hkv, Sk, D)),
    }

def reference(q, k, v):
    B, Hq, Sq, D = q.shape
    Hkv = k.shape[1]
    rep = Hq // Hkv
    k = (lambda x, n, axis: torch.repeat_interleave(x, n, dim=axis))(k, rep, axis=1)
    v = (lambda x, n, axis: torch.repeat_interleave(x, n, dim=axis))(v, rep, axis=1)
    scale = D ** -0.5
    scores = torch.einsum("bhqd,bhkd->bhqk", q, k) * scale
    p = _softmax(scores, axis=-1)
    return torch.einsum("bhqk,bhkd->bhqd", p, v)
```

```asm
; @launch grid=(256,1,1) block=(256,1,1) lds=139776
.amdgcn_target "amdgcn-amd-amdhsa--gfx950"
.text
.globl standalone__gqa_softmax__sampling_kernel
.p2align 8
.type standalone__gqa_softmax__sampling_kernel,@function
standalone__gqa_softmax__sampling_kernel:
    s_cmp_ge_u32 s2, 256
    s_cbranch_scc1 L_end
    s_load_dwordx4 s[4:7], s[0:1], 8
    s_load_dwordx2 s[32:33], s[0:1], 0
    s_load_dwordx2 s[34:35], s[0:1], 24
    v_lshrrev_b32 v3, 6, v0
    v_and_b32 v2, 63, v0
    v_readfirstlane_b32 s24, v3
    v_bfe_u32 v3, v0, 4, 2
    v_and_b32 v1, 3, v0
    v_lshlrev_b32 v1, 10, v1
    v_bfe_u32 v84, v0, 2, 1
    v_lshl_add_u32 v1, v84, 8, v1
    v_bfe_u32 v84, v0, 3, 1
    v_lshl_add_u32 v1, v84, 6, v1
    v_lshl_add_u32 v1, v3, 4, v1
    v_lshlrev_b32 v2, 4, v2
    v_and_b32 v85, 15, v0
    v_lshlrev_b32 v83, 8, v85
    v_lshl_add_u32 v83, v3, 4, v83
    s_lshl_b32 s3, s2, 20
    s_mov_b32 s10, 0x100000
    s_mov_b32 s11, 0x20000
    s_lshl_b32 s25, s24, 13
    s_add_u32 s26, s25, 4096
    s_waitcnt lgkmcnt(0)
    s_add_u32 s8, s4, s3
    s_addc_u32 s9, s5, 0
    s_mov_b32 s31, s25
    buffer_load_dwordx4 v[88:91], v1, s[8:11], s25 offen offset:0 nt
    buffer_load_dwordx4 v[92:95], v1, s[8:11], s25 offen offset:128 nt
    buffer_load_dwordx4 v[96:99], v1, s[8:11], s25 offen offset:512 nt
    buffer_load_dwordx4 v[100:103], v1, s[8:11], s25 offen offset:640 nt
    buffer_load_dwordx4 v[104:107], v1, s[8:11], s26 offen offset:0 nt
    buffer_load_dwordx4 v[108:111], v1, s[8:11], s26 offen offset:128 nt
    buffer_load_dwordx4 v[112:115], v1, s[8:11], s26 offen offset:512 nt
    buffer_load_dwordx4 v[116:119], v1, s[8:11], s26 offen offset:640 nt
    s_add_u32 s25, s25, 32768
    s_add_u32 s26, s25, 4096
    s_lshl_b32 s50, s2, 12
    s_add_u32 s16, s32, s50
    s_addc_u32 s17, s33, 0
    s_mov_b32 s18, 0x1000
    s_mov_b32 s19, 0x20000
    buffer_load_dwordx4 v[4:7], v83, s[16:19], 0 offen offset:0
    buffer_load_dwordx4 v[8:11], v83, s[16:19], 0 offen offset:64
    buffer_load_dwordx4 v[12:15], v83, s[16:19], 0 offen offset:128
    buffer_load_dwordx4 v[16:19], v83, s[16:19], 0 offen offset:192
    buffer_load_dwordx4 v[120:123], v1, s[8:11], s25 offen offset:0 nt
    buffer_load_dwordx4 v[124:127], v1, s[8:11], s25 offen offset:128 nt
    buffer_load_dwordx4 v[128:131], v1, s[8:11], s25 offen offset:512 nt
    buffer_load_dwordx4 v[132:135], v1, s[8:11], s25 offen offset:640 nt
    buffer_load_dwordx4 v[136:139], v1, s[8:11], s26 offen offset:0 nt
    buffer_load_dwordx4 v[140:143], v1, s[8:11], s26 offen offset:128 nt
    buffer_load_dwordx4 v[144:147], v1, s[8:11], s26 offen offset:512 nt
    buffer_load_dwordx4 v[148:151], v1, s[8:11], s26 offen offset:640 nt
    s_add_u32 s25, s25, 32768
    s_add_u32 s26, s25, 4096
    s_add_u32 s12, s6, s3
    s_addc_u32 s13, s7, 0
    s_mov_b32 s14, 0x100000
    s_mov_b32 s15, 0x20000
    s_add_u32 s20, s34, s50
    s_addc_u32 s21, s35, 0
    s_mov_b32 s22, 0x1000
    s_mov_b32 s23, 0x20000
    s_mov_b32 s28, 0x3e0293ee
    s_mov_b32 s29, 0x05040100
    s_mov_b32 s30, 0x07060302
    s_mov_b32 s36, 0xff00ff00
    s_mov_b32 s37, 0xff00ff00
    s_mov_b32 s38, 0x00ff00ff
    s_mov_b32 s39, 0x00ff00ff
    s_mul_i32 s3, s24, 34816
    v_add_u32 v3, s3, v2
    s_add_u32 s3, s3, 1024
    v_lshl_add_u32 v85, v85, 2, s3
    v_mov_b32 v20, 0
    v_mov_b32 v21, 0
    v_mov_b32 v22, 0
    v_mov_b32 v23, 0
    v_mov_b32 v24, 0
    v_mov_b32 v25, 0
    v_mov_b32 v26, 0
    v_mov_b32 v27, 0
    v_mov_b32 v28, 0
    v_mov_b32 v29, 0
    v_mov_b32 v30, 0
    v_mov_b32 v31, 0
    v_mov_b32 v32, 0
    v_mov_b32 v33, 0
    v_mov_b32 v34, 0
    v_mov_b32 v35, 0
    v_mov_b32 v36, 0
    v_mov_b32 v37, 0
    v_mov_b32 v38, 0
    v_mov_b32 v39, 0
    v_mov_b32 v40, 0
    v_mov_b32 v41, 0
    v_mov_b32 v42, 0
    v_mov_b32 v43, 0
    v_mov_b32 v44, 0
    v_mov_b32 v45, 0
    v_mov_b32 v46, 0
    v_mov_b32 v47, 0
    v_mov_b32 v48, 0
    v_mov_b32 v49, 0
    v_mov_b32 v50, 0
    v_mov_b32 v51, 0
    v_mov_b32 v80, 0xff800000
    v_mov_b32 v81, 0
    s_mov_b32 s27, 15
    s_waitcnt vmcnt(8)
    s_mov_b64 vcc, s[36:37]
    v_cndmask_b32_dpp v64, v88, v96, vcc row_ror:8 row_mask:0xf bank_mask:0xf
    v_cndmask_b32_dpp v65, v89, v97, vcc row_ror:8 row_mask:0xf bank_mask:0xf
    v_cndmask_b32_dpp v66, v90, v98, vcc row_ror:8 row_mask:0xf bank_mask:0xf
    v_cndmask_b32_dpp v67, v91, v99, vcc row_ror:8 row_mask:0xf bank_mask:0xf
    v_cndmask_b32_dpp v68, v92, v100, vcc row_ror:8 row_mask:0xf bank_mask:0xf
    v_cndmask_b32_dpp v69, v93, v101, vcc row_ror:8 row_mask:0xf bank_mask:0xf
    v_cndmask_b32_dpp v70, v94, v102, vcc row_ror:8 row_mask:0xf bank_mask:0xf
    v_cndmask_b32_dpp v71, v95, v103, vcc row_ror:8 row_mask:0xf bank_mask:0xf
    v_cndmask_b32_dpp v72, v104, v112, vcc row_ror:8 row_mask:0xf bank_mask:0xf
    v_cndmask_b32_dpp v73, v105, v113, vcc row_ror:8 row_mask:0xf bank_mask:0xf
    v_cndmask_b32_dpp v74, v106, v114, vcc row_ror:8 row_mask:0xf bank_mask:0xf
    v_cndmask_b32_dpp v75, v107, v115, vcc row_ror:8 row_mask:0xf bank_mask:0xf
    v_cndmask_b32_dpp v76, v108, v116, vcc row_ror:8 row_mask:0xf bank_mask:0xf
    v_cndmask_b32_dpp v77, v109, v117, vcc row_ror:8 row_mask:0xf bank_mask:0xf
    v_cndmask_b32_dpp v78, v110, v118, vcc row_ror:8 row_mask:0xf bank_mask:0xf
    v_cndmask_b32_dpp v79, v111, v119, vcc row_ror:8 row_mask:0xf bank_mask:0xf
    s_mov_b64 vcc, s[38:39]
    v_cndmask_b32_dpp v88, v96, v88, vcc row_ror:8 row_mask:0xf bank_mask:0xf
    v_cndmask_b32_dpp v89, v97, v89, vcc row_ror:8 row_mask:0xf bank_mask:0xf
    v_cndmask_b32_dpp v90, v98, v90, vcc row_ror:8 row_mask:0xf bank_mask:0xf
    v_cndmask_b32_dpp v91, v99, v91, vcc row_ror:8 row_mask:0xf bank_mask:0xf
    v_cndmask_b32_dpp v92, v100, v92, vcc row_ror:8 row_mask:0xf bank_mask:0xf
    v_cndmask_b32_dpp v93, v101, v93, vcc row_ror:8 row_mask:0xf bank_mask:0xf
    v_cndmask_b32_dpp v94, v102, v94, vcc row_ror:8 row_mask:0xf bank_mask:0xf
    v_cndmask_b32_dpp v95, v103, v95, vcc row_ror:8 row_mask:0xf bank_mask:0xf
    v_cndmask_b32_dpp v104, v112, v104, vcc row_ror:8 row_mask:0xf bank_mask:0xf
    v_cndmask_b32_dpp v105, v113, v105, vcc row_ror:8 row_mask:0xf bank_mask:0xf
    v_cndmask_b32_dpp v106, v114, v106, vcc row_ror:8 row_mask:0xf bank_mask:0xf
    v_cndmask_b32_dpp v107, v115, v107, vcc row_ror:8 row_mask:0xf bank_mask:0xf
    v_cndmask_b32_dpp v108, v116, v108, vcc row_ror:8 row_mask:0xf bank_mask:0xf
    v_cndmask_b32_dpp v109, v117, v109, vcc row_ror:8 row_mask:0xf bank_mask:0xf
    v_cndmask_b32_dpp v110, v118, v110, vcc row_ror:8 row_mask:0xf bank_mask:0xf
    v_cndmask_b32_dpp v111, v119, v111, vcc row_ror:8 row_mask:0xf bank_mask:0xf
    v_mfma_f32_16x16x32_bf16 v[52:55], v[64:67], v[8:11], 0
    v_mfma_f32_16x16x32_bf16 v[52:55], v[68:71], v[16:19], v[52:55]
    v_mfma_f32_16x16x32_bf16 v[56:59], v[72:75], v[8:11], 0
    v_mfma_f32_16x16x32_bf16 v[56:59], v[76:79], v[16:19], v[56:59]
    v_mfma_f32_16x16x32_bf16 v[52:55], v[88:91], v[4:7], v[52:55]
    v_mfma_f32_16x16x32_bf16 v[52:55], v[92:95], v[12:15], v[52:55]
    v_mfma_f32_16x16x32_bf16 v[56:59], v[104:107], v[4:7], v[56:59]
    v_mfma_f32_16x16x32_bf16 v[56:59], v[108:111], v[12:15], v[56:59]
L_k:
    s_waitcnt vmcnt(5)
    buffer_load_dwordx4 v[88:91], v1, s[8:11], s25 offen offset:0 nt
    s_nop 7
    v_max3_f32 v83, v52, v53, v54
    v_max3_f32 v84, v55, v56, v57
    v_max3_f32 v83, v83, v58, v59
    v_max_f32 v83, v83, v84
    v_mov_b32 v84, v83
    s_nop 1
    v_permlane16_swap_b32 v83, v84
    v_max_f32 v83, v83, v84
    s_waitcnt vmcnt(6)
    buffer_load_dwordx4 v[92:95], v1, s[8:11], s25 offen offset:128 nt
    v_mov_b32 v84, v83
    s_nop 1
    v_permlane32_swap_b32 v83, v84
    v_max_f32 v83, v83, v84
    v_mul_f32 v83, s28, v83
    v_max_f32 v83, v83, v80
    v_sub_f32 v82, v80, v83
    v_exp_f32 v82, v82
    v_mov_b32 v80, v83
    s_waitcnt vmcnt(5)
    buffer_load_dwordx4 v[96:99], v1, s[8:11], s25 offen offset:512 nt
    v_fma_f32 v52, v52, s28, -v83
    v_fma_f32 v53, v53, s28, -v83
    v_fma_f32 v54, v54, s28, -v83
    v_fma_f32 v55, v55, s28, -v83
    v_fma_f32 v56, v56, s28, -v83
    v_fma_f32 v57, v57, s28, -v83
    v_fma_f32 v58, v58, s28, -v83
    v_fma_f32 v59, v59, s28, -v83
    ds_write_b32 v85, v82 offset:0
    s_waitcnt vmcnt(6)
    buffer_load_dwordx4 v[100:103], v1, s[8:11], s25 offen offset:640 nt
    v_exp_f32 v52, v52
    v_exp_f32 v53, v53
    v_exp_f32 v54, v54
    v_exp_f32 v55, v55
    v_exp_f32 v56, v56
    v_exp_f32 v57, v57
    v_exp_f32 v58, v58
    v_exp_f32 v59, v59
    v_mul_f32 v81, v81, v82
    s_waitcnt vmcnt(5)
    buffer_load_dwordx4 v[104:107], v1, s[8:11], s26 offen offset:0 nt
    v_cvt_pk_bf16_f32 v60, v52, v53
    v_cvt_pk_bf16_f32 v61, v54, v55
    v_cvt_pk_bf16_f32 v62, v56, v57
    v_cvt_pk_bf16_f32 v63, v58, v59
    v_add_f32 v81, v81, v52
    v_add_f32 v83, v53, v54
    ds_write_b128 v3, v[60:63] offset:0
    v_add_f32 v84, v55, v56
    v_add_f32 v81, v81, v57
    s_waitcnt vmcnt(6)
    buffer_load_dwordx4 v[108:111], v1, s[8:11], s26 offen offset:128 nt
    v_add_f32 v83, v83, v58
    v_add_f32 v84, v84, v59
    v_add_f32 v81, v81, v83
    v_add_f32 v81, v81, v84
    s_waitcnt vmcnt(5)
    buffer_load_dwordx4 v[112:115], v1, s[8:11], s26 offen offset:512 nt
    s_mov_b64 vcc, s[36:37]
    v_cndmask_b32_dpp v64, v120, v128, vcc row_ror:8 row_mask:0xf bank_mask:0xf
    v_cndmask_b32_dpp v65, v121, v129, vcc row_ror:8 row_mask:0xf bank_mask:0xf
    v_cndmask_b32_dpp v66, v122, v130, vcc row_ror:8 row_mask:0xf bank_mask:0xf
    v_cndmask_b32_dpp v67, v123, v131, vcc row_ror:8 row_mask:0xf bank_mask:0xf
    v_cndmask_b32_dpp v68, v124, v132, vcc row_ror:8 row_mask:0xf bank_mask:0xf
    v_cndmask_b32_dpp v69, v125, v133, vcc row_ror:8 row_mask:0xf bank_mask:0xf
    v_cndmask_b32_dpp v70, v126, v134, vcc row_ror:8 row_mask:0xf bank_mask:0xf
    v_cndmask_b32_dpp v71, v127, v135, vcc row_ror:8 row_mask:0xf bank_mask:0xf
    v_cndmask_b32_dpp v72, v136, v144, vcc row_ror:8 row_mask:0xf bank_mask:0xf
    v_cndmask_b32_dpp v73, v137, v145, vcc row_ror:8 row_mask:0xf bank_mask:0xf
    v_cndmask_b32_dpp v74, v138, v146, vcc row_ror:8 row_mask:0xf bank_mask:0xf
    v_cndmask_b32_dpp v75, v139, v147, vcc row_ror:8 row_mask:0xf bank_mask:0xf
    v_cndmask_b32_dpp v76, v140, v148, vcc row_ror:8 row_mask:0xf bank_mask:0xf
    v_cndmask_b32_dpp v77, v141, v149, vcc row_ror:8 row_mask:0xf bank_mask:0xf
    v_cndmask_b32_dpp v78, v142, v150, vcc row_ror:8 row_mask:0xf bank_mask:0xf
    v_cndmask_b32_dpp v79, v143, v151, vcc row_ror:8 row_mask:0xf bank_mask:0xf
    s_mov_b64 vcc, s[38:39]
    v_cndmask_b32_dpp v120, v128, v120, vcc row_ror:8 row_mask:0xf bank_mask:0xf
    v_cndmask_b32_dpp v121, v129, v121, vcc row_ror:8 row_mask:0xf bank_mask:0xf
    v_cndmask_b32_dpp v122, v130, v122, vcc row_ror:8 row_mask:0xf bank_mask:0xf
    s_waitcnt vmcnt(6)
    buffer_load_dwordx4 v[116:119], v1, s[8:11], s26 offen offset:640 nt
    v_cndmask_b32_dpp v123, v131, v123, vcc row_ror:8 row_mask:0xf bank_mask:0xf
    v_cndmask_b32_dpp v124, v132, v124, vcc row_ror:8 row_mask:0xf bank_mask:0xf
    v_cndmask_b32_dpp v125, v133, v125, vcc row_ror:8 row_mask:0xf bank_mask:0xf
    v_cndmask_b32_dpp v126, v134, v126, vcc row_ror:8 row_mask:0xf bank_mask:0xf
    v_cndmask_b32_dpp v127, v135, v127, vcc row_ror:8 row_mask:0xf bank_mask:0xf
    v_cndmask_b32_dpp v136, v144, v136, vcc row_ror:8 row_mask:0xf bank_mask:0xf
    v_cndmask_b32_dpp v137, v145, v137, vcc row_ror:8 row_mask:0xf bank_mask:0xf
    v_cndmask_b32_dpp v138, v146, v138, vcc row_ror:8 row_mask:0xf bank_mask:0xf
    v_cndmask_b32_dpp v139, v147, v139, vcc row_ror:8 row_mask:0xf bank_mask:0xf
    v_cndmask_b32_dpp v140, v148, v140, vcc row_ror:8 row_mask:0xf bank_mask:0xf
    v_cndmask_b32_dpp v141, v149, v141, vcc row_ror:8 row_mask:0xf bank_mask:0xf
    v_cndmask_b32_dpp v142, v150, v142, vcc row_ror:8 row_mask:0xf bank_mask:0xf
    v_cndmask_b32_dpp v143, v151, v143, vcc row_ror:8 row_mask:0xf bank_mask:0xf
    v_mfma_f32_16x16x32_bf16 v[52:55], v[64:67], v[8:11], 0
    v_mfma_f32_16x16x32_bf16 v[52:55], v[68:71], v[16:19], v[52:55]
    v_mfma_f32_16x16x32_bf16 v[56:59], v[72:75], v[8:11], 0
    v_mfma_f32_16x16x32_bf16 v[56:59], v[76:79], v[16:19], v[56:59]
    v_mfma_f32_16x16x32_bf16 v[52:55], v[120:123], v[4:7], v[52:55]
    v_mfma_f32_16x16x32_bf16 v[52:55], v[124:127], v[12:15], v[52:55]
    v_mfma_f32_16x16x32_bf16 v[56:59], v[136:139], v[4:7], v[56:59]
    v_mfma_f32_16x16x32_bf16 v[56:59], v[140:143], v[12:15], v[56:59]
    s_add_u32 s25, s25, 32768
    s_add_u32 s26, s25, 4096
    s_waitcnt vmcnt(5)
    buffer_load_dwordx4 v[120:123], v1, s[8:11], s25 offen offset:0 nt
    s_nop 7
    v_max3_f32 v83, v52, v53, v54
    v_max3_f32 v84, v55, v56, v57
    v_max3_f32 v83, v83, v58, v59
    v_max_f32 v83, v83, v84
    v_mov_b32 v84, v83
    s_nop 1
    v_permlane16_swap_b32 v83, v84
    v_max_f32 v83, v83, v84
    s_waitcnt vmcnt(6)
    buffer_load_dwordx4 v[124:127], v1, s[8:11], s25 offen offset:128 nt
    v_mov_b32 v84, v83
    s_nop 1
    v_permlane32_swap_b32 v83, v84
    v_max_f32 v83, v83, v84
    v_mul_f32 v83, s28, v83
    v_max_f32 v83, v83, v80
    v_sub_f32 v82, v80, v83
    v_exp_f32 v82, v82
    v_mov_b32 v80, v83
    s_waitcnt vmcnt(5)
    buffer_load_dwordx4 v[128:131], v1, s[8:11], s25 offen offset:512 nt
    v_fma_f32 v52, v52, s28, -v83
    v_fma_f32 v53, v53, s28, -v83
    v_fma_f32 v54, v54, s28, -v83
    v_fma_f32 v55, v55, s28, -v83
    v_fma_f32 v56, v56, s28, -v83
    v_fma_f32 v57, v57, s28, -v83
    v_fma_f32 v58, v58, s28, -v83
    v_fma_f32 v59, v59, s28, -v83
    ds_write_b32 v85, v82 offset:1088
    s_waitcnt vmcnt(6)
    buffer_load_dwordx4 v[132:135], v1, s[8:11], s25 offen offset:640 nt
    v_exp_f32 v52, v52
    v_exp_f32 v53, v53
    v_exp_f32 v54, v54
    v_exp_f32 v55, v55
    v_exp_f32 v56, v56
    v_exp_f32 v57, v57
    v_exp_f32 v58, v58
    v_exp_f32 v59, v59
    v_mul_f32 v81, v81, v82
    s_waitcnt vmcnt(5)
    buffer_load_dwordx4 v[136:139], v1, s[8:11], s26 offen offset:0 nt
    v_cvt_pk_bf16_f32 v60, v52, v53
    v_cvt_pk_bf16_f32 v61, v54, v55
    v_cvt_pk_bf16_f32 v62, v56, v57
    v_cvt_pk_bf16_f32 v63, v58, v59
    v_add_f32 v81, v81, v52
    v_add_f32 v83, v53, v54
    ds_write_b128 v3, v[60:63] offset:1088
    v_add_f32 v84, v55, v56
    v_add_f32 v81, v81, v57
    s_waitcnt vmcnt(6)
    buffer_load_dwordx4 v[140:143], v1, s[8:11], s26 offen offset:128 nt
    v_add_f32 v83, v83, v58
    v_add_f32 v84, v84, v59
    v_add_f32 v81, v81, v83
    v_add_f32 v81, v81, v84
    s_waitcnt vmcnt(5)
    buffer_load_dwordx4 v[144:147], v1, s[8:11], s26 offen offset:512 nt
    s_mov_b64 vcc, s[36:37]
    v_cndmask_b32_dpp v64, v88, v96, vcc row_ror:8 row_mask:0xf bank_mask:0xf
    v_cndmask_b32_dpp v65, v89, v97, vcc row_ror:8 row_mask:0xf bank_mask:0xf
    v_cndmask_b32_dpp v66, v90, v98, vcc row_ror:8 row_mask:0xf bank_mask:0xf
    v_cndmask_b32_dpp v67, v91, v99, vcc row_ror:8 row_mask:0xf bank_mask:0xf
    v_cndmask_b32_dpp v68, v92, v100, vcc row_ror:8 row_mask:0xf bank_mask:0xf
    v_cndmask_b32_dpp v69, v93, v101, vcc row_ror:8 row_mask:0xf bank_mask:0xf
    v_cndmask_b32_dpp v70, v94, v102, vcc row_ror:8 row_mask:0xf bank_mask:0xf
    v_cndmask_b32_dpp v71, v95, v103, vcc row_ror:8 row_mask:0xf bank_mask:0xf
    v_cndmask_b32_dpp v72, v104, v112, vcc row_ror:8 row_mask:0xf bank_mask:0xf
    v_cndmask_b32_dpp v73, v105, v113, vcc row_ror:8 row_mask:0xf bank_mask:0xf
    v_cndmask_b32_dpp v74, v106, v114, vcc row_ror:8 row_mask:0xf bank_mask:0xf
    v_cndmask_b32_dpp v75, v107, v115, vcc row_ror:8 row_mask:0xf bank_mask:0xf
    v_cndmask_b32_dpp v76, v108, v116, vcc row_ror:8 row_mask:0xf bank_mask:0xf
    v_cndmask_b32_dpp v77, v109, v117, vcc row_ror:8 row_mask:0xf bank_mask:0xf
    v_cndmask_b32_dpp v78, v110, v118, vcc row_ror:8 row_mask:0xf bank_mask:0xf
    v_cndmask_b32_dpp v79, v111, v119, vcc row_ror:8 row_mask:0xf bank_mask:0xf
    s_mov_b64 vcc, s[38:39]
    v_cndmask_b32_dpp v88, v96, v88, vcc row_ror:8 row_mask:0xf bank_mask:0xf
    v_cndmask_b32_dpp v89, v97, v89, vcc row_ror:8 row_mask:0xf bank_mask:0xf
    v_cndmask_b32_dpp v90, v98, v90, vcc row_ror:8 row_mask:0xf bank_mask:0xf
    s_waitcnt vmcnt(6)
    buffer_load_dwordx4 v[148:151], v1, s[8:11], s26 offen offset:640 nt
    v_cndmask_b32_dpp v91, v99, v91, vcc row_ror:8 row_mask:0xf bank_mask:0xf
    v_cndmask_b32_dpp v92, v100, v92, vcc row_ror:8 row_mask:0xf bank_mask:0xf
    v_cndmask_b32_dpp v93, v101, v93, vcc row_ror:8 row_mask:0xf bank_mask:0xf
    v_cndmask_b32_dpp v94, v102, v94, vcc row_ror:8 row_mask:0xf bank_mask:0xf
    v_cndmask_b32_dpp v95, v103, v95, vcc row_ror:8 row_mask:0xf bank_mask:0xf
    v_cndmask_b32_dpp v104, v112, v104, vcc row_ror:8 row_mask:0xf bank_mask:0xf
    v_cndmask_b32_dpp v105, v113, v105, vcc row_ror:8 row_mask:0xf bank_mask:0xf
    v_cndmask_b32_dpp v106, v114, v106, vcc row_ror:8 row_mask:0xf bank_mask:0xf
    v_cndmask_b32_dpp v107, v115, v107, vcc row_ror:8 row_mask:0xf bank_mask:0xf
    v_cndmask_b32_dpp v108, v116, v108, vcc row_ror:8 row_mask:0xf bank_mask:0xf
    v_cndmask_b32_dpp v109, v117, v109, vcc row_ror:8 row_mask:0xf bank_mask:0xf
    v_cndmask_b32_dpp v110, v118, v110, vcc row_ror:8 row_mask:0xf bank_mask:0xf
    v_cndmask_b32_dpp v111, v119, v111, vcc row_ror:8 row_mask:0xf bank_mask:0xf
    v_mfma_f32_16x16x32_bf16 v[52:55], v[64:67], v[8:11], 0
    v_mfma_f32_16x16x32_bf16 v[52:55], v[68:71], v[16:19], v[52:55]
    v_mfma_f32_16x16x32_bf16 v[56:59], v[72:75], v[8:11], 0
    v_mfma_f32_16x16x32_bf16 v[56:59], v[76:79], v[16:19], v[56:59]
    v_mfma_f32_16x16x32_bf16 v[52:55], v[88:91], v[4:7], v[52:55]
    v_mfma_f32_16x16x32_bf16 v[52:55], v[92:95], v[12:15], v[52:55]
    v_mfma_f32_16x16x32_bf16 v[56:59], v[104:107], v[4:7], v[56:59]
    v_mfma_f32_16x16x32_bf16 v[56:59], v[108:111], v[12:15], v[56:59]
    s_add_u32 s25, s25, 32768
    s_add_u32 s26, s25, 4096
    v_add_u32 v3, 2176, v3
    v_add_u32 v85, 2176, v85
    s_sub_u32 s27, s27, 1
    s_cmp_lg_u32 s27, 0
    s_cbranch_scc1 L_k
    s_mov_b32 s25, s31
    s_add_u32 s26, s25, 4096
    s_waitcnt vmcnt(4)
    buffer_load_dwordx4 v[88:91], v2, s[12:15], s25 offen offset:0 nt
    s_nop 7
    v_max3_f32 v83, v52, v53, v54
    v_max3_f32 v84, v55, v56, v57
    v_max3_f32 v83, v83, v58, v59
    v_max_f32 v83, v83, v84
    v_mov_b32 v84, v83
    s_nop 1
    v_permlane16_swap_b32 v83, v84
    v_max_f32 v83, v83, v84
    v_mov_b32 v84, v83
    s_nop 1
    v_permlane32_swap_b32 v83, v84
    v_max_f32 v83, v83, v84
    s_waitcnt vmcnt(4)
    buffer_load_dwordx4 v[92:95], v2, s[12:15], s25 offen offset:1024 nt
    v_mul_f32 v83, s28, v83
    v_max_f32 v83, v83, v80
    v_sub_f32 v82, v80, v83
    v_exp_f32 v82, v82
    v_mov_b32 v80, v83
    v_fma_f32 v52, v52, s28, -v83
    v_fma_f32 v53, v53, s28, -v83
    v_fma_f32 v54, v54, s28, -v83
    v_fma_f32 v55, v55, s28, -v83
    v_fma_f32 v56, v56, s28, -v83
    v_fma_f32 v57, v57, s28, -v83
    v_fma_f32 v58, v58, s28, -v83
    v_fma_f32 v59, v59, s28, -v83
    s_waitcnt vmcnt(5)
    buffer_load_dwordx4 v[96:99], v2, s[12:15], s25 offen offset:2048 nt
    ds_write_b32 v85, v82 offset:0
    v_exp_f32 v52, v52
    v_exp_f32 v53, v53
    v_exp_f32 v54, v54
    v_exp_f32 v55, v55
    v_exp_f32 v56, v56
    v_exp_f32 v57, v57
    v_exp_f32 v58, v58
    v_exp_f32 v59, v59
    v_mul_f32 v81, v81, v82
    v_cvt_pk_bf16_f32 v60, v52, v53
    v_cvt_pk_bf16_f32 v61, v54, v55
    v_cvt_pk_bf16_f32 v62, v56, v57
    s_waitcnt vmcnt(4)
    buffer_load_dwordx4 v[100:103], v2, s[12:15], s25 offen offset:3072 nt
    v_cvt_pk_bf16_f32 v63, v58, v59
    v_add_f32 v81, v81, v52
    v_add_f32 v83, v53, v54
    ds_write_b128 v3, v[60:63] offset:0
    v_add_f32 v84, v55, v56
    v_add_f32 v81, v81, v57
    v_add_f32 v83, v83, v58
    v_add_f32 v84, v84, v59
    v_add_f32 v81, v81, v83
    v_add_f32 v81, v81, v84
    s_waitcnt vmcnt(4)
    buffer_load_dwordx4 v[104:107], v2, s[12:15], s26 offen offset:0 nt
    s_mov_b64 vcc, s[36:37]
    v_cndmask_b32_dpp v64, v120, v128, vcc row_ror:8 row_mask:0xf bank_mask:0xf
    v_cndmask_b32_dpp v65, v121, v129, vcc row_ror:8 row_mask:0xf bank_mask:0xf
    v_cndmask_b32_dpp v66, v122, v130, vcc row_ror:8 row_mask:0xf bank_mask:0xf
    v_cndmask_b32_dpp v67, v123, v131, vcc row_ror:8 row_mask:0xf bank_mask:0xf
    v_cndmask_b32_dpp v68, v124, v132, vcc row_ror:8 row_mask:0xf bank_mask:0xf
    v_cndmask_b32_dpp v69, v125, v133, vcc row_ror:8 row_mask:0xf bank_mask:0xf
    v_cndmask_b32_dpp v70, v126, v134, vcc row_ror:8 row_mask:0xf bank_mask:0xf
    v_cndmask_b32_dpp v71, v127, v135, vcc row_ror:8 row_mask:0xf bank_mask:0xf
    v_cndmask_b32_dpp v72, v136, v144, vcc row_ror:8 row_mask:0xf bank_mask:0xf
    v_cndmask_b32_dpp v73, v137, v145, vcc row_ror:8 row_mask:0xf bank_mask:0xf
    s_waitcnt vmcnt(5)
    buffer_load_dwordx4 v[108:111], v2, s[12:15], s26 offen offset:1024 nt
    v_cndmask_b32_dpp v74, v138, v146, vcc row_ror:8 row_mask:0xf bank_mask:0xf
    v_cndmask_b32_dpp v75, v139, v147, vcc row_ror:8 row_mask:0xf bank_mask:0xf
    v_cndmask_b32_dpp v76, v140, v148, vcc row_ror:8 row_mask:0xf bank_mask:0xf
    v_cndmask_b32_dpp v77, v141, v149, vcc row_ror:8 row_mask:0xf bank_mask:0xf
    v_cndmask_b32_dpp v78, v142, v150, vcc row_ror:8 row_mask:0xf bank_mask:0xf
    v_cndmask_b32_dpp v79, v143, v151, vcc row_ror:8 row_mask:0xf bank_mask:0xf
    s_mov_b64 vcc, s[38:39]
    v_cndmask_b32_dpp v120, v128, v120, vcc row_ror:8 row_mask:0xf bank_mask:0xf
    v_cndmask_b32_dpp v121, v129, v121, vcc row_ror:8 row_mask:0xf bank_mask:0xf
    v_cndmask_b32_dpp v122, v130, v122, vcc row_ror:8 row_mask:0xf bank_mask:0xf
    v_cndmask_b32_dpp v123, v131, v123, vcc row_ror:8 row_mask:0xf bank_mask:0xf
    s_waitcnt vmcnt(4)
    buffer_load_dwordx4 v[112:115], v2, s[12:15], s26 offen offset:2048 nt
    v_cndmask_b32_dpp v124, v132, v124, vcc row_ror:8 row_mask:0xf bank_mask:0xf
    v_cndmask_b32_dpp v125, v133, v125, vcc row_ror:8 row_mask:0xf bank_mask:0xf
    v_cndmask_b32_dpp v126, v134, v126, vcc row_ror:8 row_mask:0xf bank_mask:0xf
    v_cndmask_b32_dpp v127, v135, v127, vcc row_ror:8 row_mask:0xf bank_mask:0xf
    v_cndmask_b32_dpp v136, v144, v136, vcc row_ror:8 row_mask:0xf bank_mask:0xf
    v_cndmask_b32_dpp v137, v145, v137, vcc row_ror:8 row_mask:0xf bank_mask:0xf
    v_cndmask_b32_dpp v138, v146, v138, vcc row_ror:8 row_mask:0xf bank_mask:0xf
    v_cndmask_b32_dpp v139, v147, v139, vcc row_ror:8 row_mask:0xf bank_mask:0xf
    v_cndmask_b32_dpp v140, v148, v140, vcc row_ror:8 row_mask:0xf bank_mask:0xf
    v_cndmask_b32_dpp v141, v149, v141, vcc row_ror:8 row_mask:0xf bank_mask:0xf
    v_cndmask_b32_dpp v142, v150, v142, vcc row_ror:8 row_mask:0xf bank_mask:0xf
    s_waitcnt vmcnt(4)
    buffer_load_dwordx4 v[116:119], v2, s[12:15], s26 offen offset:3072 nt
    v_cndmask_b32_dpp v143, v151, v143, vcc row_ror:8 row_mask:0xf bank_mask:0xf
    v_mfma_f32_16x16x32_bf16 v[52:55], v[64:67], v[8:11], 0
    v_mfma_f32_16x16x32_bf16 v[52:55], v[68:71], v[16:19], v[52:55]
    v_mfma_f32_16x16x32_bf16 v[56:59], v[72:75], v[8:11], 0
    v_mfma_f32_16x16x32_bf16 v[56:59], v[76:79], v[16:19], v[56:59]
    v_mfma_f32_16x16x32_bf16 v[52:55], v[120:123], v[4:7], v[52:55]
    v_mfma_f32_16x16x32_bf16 v[52:55], v[124:127], v[12:15], v[52:55]
    v_mfma_f32_16x16x32_bf16 v[56:59], v[136:139], v[4:7], v[56:59]
    v_mfma_f32_16x16x32_bf16 v[56:59], v[140:143], v[12:15], v[56:59]
    s_add_u32 s25, s25, 32768
    s_add_u32 s26, s25, 4096
    s_waitcnt vmcnt(4)
    buffer_load_dwordx4 v[120:123], v2, s[12:15], s25 offen offset:0 nt
    s_nop 7
    v_max3_f32 v83, v52, v53, v54
    v_max3_f32 v84, v55, v56, v57
    v_max3_f32 v83, v83, v58, v59
    v_max_f32 v83, v83, v84
    v_mov_b32 v84, v83
    s_nop 1
    v_permlane16_swap_b32 v83, v84
    v_max_f32 v83, v83, v84
    v_mov_b32 v84, v83
    s_nop 1
    v_permlane32_swap_b32 v83, v84
    v_max_f32 v83, v83, v84
    v_mul_f32 v83, s28, v83
    v_max_f32 v83, v83, v80
    v_sub_f32 v82, v80, v83
    v_exp_f32 v82, v82
    s_waitcnt vmcnt(4)
    buffer_load_dwordx4 v[124:127], v2, s[12:15], s25 offen offset:1024 nt
    v_mov_b32 v80, v83
    v_fma_f32 v52, v52, s28, -v83
    v_fma_f32 v53, v53, s28, -v83
    v_fma_f32 v54, v54, s28, -v83
    v_fma_f32 v55, v55, s28, -v83
    v_fma_f32 v56, v56, s28, -v83
    v_fma_f32 v57, v57, s28, -v83
    v_fma_f32 v58, v58, s28, -v83
    v_fma_f32 v59, v59, s28, -v83
    ds_write_b32 v85, v82 offset:1088
    v_exp_f32 v52, v52
    v_exp_f32 v53, v53
    v_exp_f32 v54, v54
    v_exp_f32 v55, v55
    v_exp_f32 v56, v56
    v_exp_f32 v57, v57
    v_exp_f32 v58, v58
    s_waitcnt vmcnt(5)
    buffer_load_dwordx4 v[128:131], v2, s[12:15], s25 offen offset:2048 nt
    v_exp_f32 v59, v59
    v_mul_f32 v81, v81, v82
    v_cvt_pk_bf16_f32 v60, v52, v53
    v_cvt_pk_bf16_f32 v61, v54, v55
    v_cvt_pk_bf16_f32 v62, v56, v57
    v_cvt_pk_bf16_f32 v63, v58, v59
    v_add_f32 v81, v81, v52
    v_add_f32 v83, v53, v54
    ds_write_b128 v3, v[60:63] offset:1088
    v_add_f32 v84, v55, v56
    v_add_f32 v81, v81, v57
    v_add_f32 v83, v83, v58
    v_add_f32 v84, v84, v59
    v_add_f32 v81, v81, v83
    v_add_f32 v81, v81, v84
    v_mov_b32 v84, v81
    v_subrev_u32 v3, 32640, v3
    s_waitcnt vmcnt(4)
    buffer_load_dwordx4 v[132:135], v2, s[12:15], s25 offen offset:3072 nt
    v_subrev_u32 v85, 32640, v85
    v_permlane16_swap_b32 v81, v84
    v_add_f32 v81, v81, v84
    v_mov_b32 v84, v81
    v_and_b32 v83, 15, v0
    s_lshl_b32 s3, s24, 3
    v_permlane32_swap_b32 v81, v84
    v_add_f32 v81, v81, v84
    s_add_u32 s3, s3, 139264
    v_lshl_add_u32 v83, v83, 5, s3
    ds_write_b64 v83, v[80:81]
    ds_read_b32 v82, v85 offset:0
    ds_read_b128 v[60:63], v3 offset:0
    s_waitcnt lgkmcnt(0)
    s_waitcnt vmcnt(4)
    buffer_load_dwordx4 v[136:139], v2, s[12:15], s26 offen offset:0 nt
    v_perm_b32 v64, v92, v88, s29
    v_perm_b32 v65, v100, v96, s29
    v_perm_b32 v66, v108, v104, s29
    v_perm_b32 v67, v116, v112, s29
    v_perm_b32 v68, v92, v88, s30
    v_perm_b32 v69, v100, v96, s30
    v_perm_b32 v70, v108, v104, s30
    v_perm_b32 v71, v116, v112, s30
    v_mfma_f32_16x16x32_bf16 v[20:23], v[64:67], v[60:63], v[20:23]
    v_perm_b32 v72, v93, v89, s29
    v_perm_b32 v73, v101, v97, s29
    s_waitcnt vmcnt(5)
    buffer_load_dwordx4 v[140:143], v2, s[12:15], s26 offen offset:1024 nt
    v_perm_b32 v74, v109, v105, s29
    v_perm_b32 v75, v117, v113, s29
    v_mfma_f32_16x16x32_bf16 v[24:27], v[68:71], v[60:63], v[24:27]
    v_perm_b32 v76, v93, v89, s30
    v_perm_b32 v77, v101, v97, s30
    v_perm_b32 v78, v109, v105, s30
    v_perm_b32 v79, v117, v113, s30
    v_mfma_f32_16x16x32_bf16 v[28:31], v[72:75], v[60:63], v[28:31]
    v_perm_b32 v64, v94, v90, s29
    v_perm_b32 v65, v102, v98, s29
    v_perm_b32 v66, v110, v106, s29
    s_waitcnt vmcnt(4)
    buffer_load_dwordx4 v[144:147], v2, s[12:15], s26 offen offset:2048 nt
    v_perm_b32 v67, v118, v114, s29
    v_mfma_f32_16x16x32_bf16 v[32:35], v[76:79], v[60:63], v[32:35]
    v_perm_b32 v68, v94, v90, s30
    v_perm_b32 v69, v102, v98, s30
    v_perm_b32 v70, v110, v106, s30
    v_perm_b32 v71, v118, v114, s30
    v_mfma_f32_16x16x32_bf16 v[36:39], v[64:67], v[60:63], v[36:39]
    v_perm_b32 v72, v95, v91, s29
    v_perm_b32 v73, v103, v99, s29
    v_perm_b32 v74, v111, v107, s29
    v_perm_b32 v75, v119, v115, s29
    s_waitcnt vmcnt(4)
    buffer_load_dwordx4 v[148:151], v2, s[12:15], s26 offen offset:3072 nt
    v_mfma_f32_16x16x32_bf16 v[40:43], v[68:71], v[60:63], v[40:43]
    v_perm_b32 v76, v95, v91, s30
    v_perm_b32 v77, v103, v99, s30
    v_perm_b32 v78, v111, v107, s30
    v_perm_b32 v79, v119, v115, s30
    v_mfma_f32_16x16x32_bf16 v[44:47], v[72:75], v[60:63], v[44:47]
    s_nop 1
    v_mfma_f32_16x16x32_bf16 v[48:51], v[76:79], v[60:63], v[48:51]
    s_add_u32 s25, s25, 32768
    s_add_u32 s26, s25, 4096
    s_mov_b32 s27, 13
L_v:
    s_waitcnt vmcnt(4)
    buffer_load_dwordx4 v[88:91], v2, s[12:15], s25 offen offset:0 nt
    ds_read_b32 v82, v85 offset:1088
    ds_read_b128 v[60:63], v3 offset:1088
    s_waitcnt vmcnt(4)
    buffer_load_dwordx4 v[92:95], v2, s[12:15], s25 offen offset:1024 nt
    s_waitcnt lgkmcnt(0)
    v_mul_f32 v20, v20, v82
    v_mul_f32 v21, v21, v82
    v_mul_f32 v22, v22, v82
    v_mul_f32 v23, v23, v82
    v_mul_f32 v24, v24, v82
    v_mul_f32 v25, v25, v82
    v_mul_f32 v26, v26, v82
    v_mul_f32 v27, v27, v82
    v_mul_f32 v28, v28, v82
    v_mul_f32 v29, v29, v82
    s_waitcnt vmcnt(5)
    buffer_load_dwordx4 v[96:99], v2, s[12:15], s25 offen offset:2048 nt
    v_mul_f32 v30, v30, v82
    v_mul_f32 v31, v31, v82
    v_mul_f32 v32, v32, v82
    v_mul_f32 v33, v33, v82
    v_mul_f32 v34, v34, v82
    v_mul_f32 v35, v35, v82
    v_mul_f32 v36, v36, v82
    v_mul_f32 v37, v37, v82
    v_mul_f32 v38, v38, v82
    v_mul_f32 v39, v39, v82
    v_mul_f32 v40, v40, v82
    s_waitcnt vmcnt(4)
    buffer_load_dwordx4 v[100:103], v2, s[12:15], s25 offen offset:3072 nt
    v_mul_f32 v41, v41, v82
    v_mul_f32 v42, v42, v82
    v_mul_f32 v43, v43, v82
    v_mul_f32 v44, v44, v82
    v_mul_f32 v45, v45, v82
    v_mul_f32 v46, v46, v82
    v_mul_f32 v47, v47, v82
    v_mul_f32 v48, v48, v82
    v_mul_f32 v49, v49, v82
    v_mul_f32 v50, v50, v82
    v_mul_f32 v51, v51, v82
    s_waitcnt vmcnt(4)
    buffer_load_dwordx4 v[104:107], v2, s[12:15], s26 offen offset:0 nt
    v_perm_b32 v64, v124, v120, s29
    v_perm_b32 v65, v132, v128, s29
    v_perm_b32 v66, v140, v136, s29
    v_perm_b32 v67, v148, v144, s29
    v_perm_b32 v68, v124, v120, s30
    v_perm_b32 v69, v132, v128, s30
    v_perm_b32 v70, v140, v136, s30
    v_perm_b32 v71, v148, v144, s30
    v_mfma_f32_16x16x32_bf16 v[20:23], v[64:67], v[60:63], v[20:23]
    v_perm_b32 v72, v125, v121, s29
    v_perm_b32 v73, v133, v129, s29
    s_waitcnt vmcnt(5)
    buffer_load_dwordx4 v[108:111], v2, s[12:15], s26 offen offset:1024 nt
    v_perm_b32 v74, v141, v137, s29
    v_perm_b32 v75, v149, v145, s29
    v_mfma_f32_16x16x32_bf16 v[24:27], v[68:71], v[60:63], v[24:27]
    v_perm_b32 v76, v125, v121, s30
    v_perm_b32 v77, v133, v129, s30
    v_perm_b32 v78, v141, v137, s30
    v_perm_b32 v79, v149, v145, s30
    v_mfma_f32_16x16x32_bf16 v[28:31], v[72:75], v[60:63], v[28:31]
    v_perm_b32 v64, v126, v122, s29
    v_perm_b32 v65, v134, v130, s29
    v_perm_b32 v66, v142, v138, s29
    s_waitcnt vmcnt(4)
    buffer_load_dwordx4 v[112:115], v2, s[12:15], s26 offen offset:2048 nt
    v_perm_b32 v67, v150, v146, s29
    v_mfma_f32_16x16x32_bf16 v[32:35], v[76:79], v[60:63], v[32:35]
    v_perm_b32 v68, v126, v122, s30
    v_perm_b32 v69, v134, v130, s30
    v_perm_b32 v70, v142, v138, s30
    v_perm_b32 v71, v150, v146, s30
    v_mfma_f32_16x16x32_bf16 v[36:39], v[64:67], v[60:63], v[36:39]
    v_perm_b32 v72, v127, v123, s29
    v_perm_b32 v73, v135, v131, s29
    v_perm_b32 v74, v143, v139, s29
    v_perm_b32 v75, v151, v147, s29
    s_waitcnt vmcnt(4)
    buffer_load_dwordx4 v[116:119], v2, s[12:15], s26 offen offset:3072 nt
    v_mfma_f32_16x16x32_bf16 v[40:43], v[68:71], v[60:63], v[40:43]
    v_perm_b32 v76, v127, v123, s30
    v_perm_b32 v77, v135, v131, s30
    v_perm_b32 v78, v143, v139, s30
    v_perm_b32 v79, v151, v147, s30
    v_mfma_f32_16x16x32_bf16 v[44:47], v[72:75], v[60:63], v[44:47]
    s_nop 1
    v_mfma_f32_16x16x32_bf16 v[48:51], v[76:79], v[60:63], v[48:51]
    s_add_u32 s25, s25, 32768
    s_add_u32 s26, s25, 4096
    s_waitcnt vmcnt(4)
    buffer_load_dwordx4 v[120:123], v2, s[12:15], s25 offen offset:0 nt
    ds_read_b32 v82, v85 offset:2176
    ds_read_b128 v[60:63], v3 offset:2176
    s_waitcnt vmcnt(4)
    buffer_load_dwordx4 v[124:127], v2, s[12:15], s25 offen offset:1024 nt
    s_waitcnt lgkmcnt(0)
    v_mul_f32 v20, v20, v82
    v_mul_f32 v21, v21, v82
    v_mul_f32 v22, v22, v82
    v_mul_f32 v23, v23, v82
    v_mul_f32 v24, v24, v82
    v_mul_f32 v25, v25, v82
    v_mul_f32 v26, v26, v82
    v_mul_f32 v27, v27, v82
    v_mul_f32 v28, v28, v82
    v_mul_f32 v29, v29, v82
    s_waitcnt vmcnt(5)
    buffer_load_dwordx4 v[128:131], v2, s[12:15], s25 offen offset:2048 nt
    v_mul_f32 v30, v30, v82
    v_mul_f32 v31, v31, v82
    v_mul_f32 v32, v32, v82
    v_mul_f32 v33, v33, v82
    v_mul_f32 v34, v34, v82
    v_mul_f32 v35, v35, v82
    v_mul_f32 v36, v36, v82
    v_mul_f32 v37, v37, v82
    v_mul_f32 v38, v38, v82
    v_mul_f32 v39, v39, v82
    v_mul_f32 v40, v40, v82
    s_waitcnt vmcnt(4)
    buffer_load_dwordx4 v[132:135], v2, s[12:15], s25 offen offset:3072 nt
    v_mul_f32 v41, v41, v82
    v_mul_f32 v42, v42, v82
    v_mul_f32 v43, v43, v82
    v_mul_f32 v44, v44, v82
    v_mul_f32 v45, v45, v82
    v_mul_f32 v46, v46, v82
    v_mul_f32 v47, v47, v82
    v_mul_f32 v48, v48, v82
    v_mul_f32 v49, v49, v82
    v_mul_f32 v50, v50, v82
    v_mul_f32 v51, v51, v82
    s_waitcnt vmcnt(4)
    buffer_load_dwordx4 v[136:139], v2, s[12:15], s26 offen offset:0 nt
    v_perm_b32 v64, v92, v88, s29
    v_perm_b32 v65, v100, v96, s29
    v_perm_b32 v66, v108, v104, s29
    v_perm_b32 v67, v116, v112, s29
    v_perm_b32 v68, v92, v88, s30
    v_perm_b32 v69, v100, v96, s30
    v_perm_b32 v70, v108, v104, s30
    v_perm_b32 v71, v116, v112, s30
    v_mfma_f32_16x16x32_bf16 v[20:23], v[64:67], v[60:63], v[20:23]
    v_perm_b32 v72, v93, v89, s29
    v_perm_b32 v73, v101, v97, s29
    s_waitcnt vmcnt(5)
    buffer_load_dwordx4 v[140:143], v2, s[12:15], s26 offen offset:1024 nt
    v_perm_b32 v74, v109, v105, s29
    v_perm_b32 v75, v117, v113, s29
    v_mfma_f32_16x16x32_bf16 v[24:27], v[68:71], v[60:63], v[24:27]
    v_perm_b32 v76, v93, v89, s30
    v_perm_b32 v77, v101, v97, s30
    v_perm_b32 v78, v109, v105, s30
    v_perm_b32 v79, v117, v113, s30
    v_mfma_f32_16x16x32_bf16 v[28:31], v[72:75], v[60:63], v[28:31]
    v_perm_b32 v64, v94, v90, s29
    v_perm_b32 v65, v102, v98, s29
    v_perm_b32 v66, v110, v106, s29
    s_waitcnt vmcnt(4)
    buffer_load_dwordx4 v[144:147], v2, s[12:15], s26 offen offset:2048 nt
    v_perm_b32 v67, v118, v114, s29
    v_mfma_f32_16x16x32_bf16 v[32:35], v[76:79], v[60:63], v[32:35]
    v_perm_b32 v68, v94, v90, s30
    v_perm_b32 v69, v102, v98, s30
    v_perm_b32 v70, v110, v106, s30
    v_perm_b32 v71, v118, v114, s30
    v_mfma_f32_16x16x32_bf16 v[36:39], v[64:67], v[60:63], v[36:39]
    v_perm_b32 v72, v95, v91, s29
    v_perm_b32 v73, v103, v99, s29
    v_perm_b32 v74, v111, v107, s29
    v_perm_b32 v75, v119, v115, s29
    s_waitcnt vmcnt(4)
    buffer_load_dwordx4 v[148:151], v2, s[12:15], s26 offen offset:3072 nt
    v_mfma_f32_16x16x32_bf16 v[40:43], v[68:71], v[60:63], v[40:43]
    v_perm_b32 v76, v95, v91, s30
    v_perm_b32 v77, v103, v99, s30
    v_perm_b32 v78, v111, v107, s30
    v_perm_b32 v79, v119, v115, s30
    v_mfma_f32_16x16x32_bf16 v[44:47], v[72:75], v[60:63], v[44:47]
    s_nop 1
    v_mfma_f32_16x16x32_bf16 v[48:51], v[76:79], v[60:63], v[48:51]
    s_add_u32 s25, s25, 32768
    s_add_u32 s26, s25, 4096
    v_add_u32 v3, 2176, v3
    v_add_u32 v85, 2176, v85
    s_sub_u32 s27, s27, 1
    s_cmp_lg_u32 s27, 0
    s_cbranch_scc1 L_v
    buffer_load_dwordx4 v[88:91], v2, s[12:15], s25 offen offset:0 nt
    buffer_load_dwordx4 v[92:95], v2, s[12:15], s25 offen offset:1024 nt
    buffer_load_dwordx4 v[96:99], v2, s[12:15], s25 offen offset:2048 nt
    buffer_load_dwordx4 v[100:103], v2, s[12:15], s25 offen offset:3072 nt
    buffer_load_dwordx4 v[104:107], v2, s[12:15], s26 offen offset:0 nt
    buffer_load_dwordx4 v[108:111], v2, s[12:15], s26 offen offset:1024 nt
    buffer_load_dwordx4 v[112:115], v2, s[12:15], s26 offen offset:2048 nt
    buffer_load_dwordx4 v[116:119], v2, s[12:15], s26 offen offset:3072 nt
    s_add_u32 s25, s25, 32768
    s_add_u32 s26, s25, 4096
    buffer_load_dwordx4 v[152:155], v2, s[12:15], s25 offen offset:0 nt
    buffer_load_dwordx4 v[156:159], v2, s[12:15], s25 offen offset:1024 nt
    buffer_load_dwordx4 v[160:163], v2, s[12:15], s25 offen offset:2048 nt
    buffer_load_dwordx4 v[164:167], v2, s[12:15], s25 offen offset:3072 nt
    buffer_load_dwordx4 v[168:171], v2, s[12:15], s26 offen offset:0 nt
    buffer_load_dwordx4 v[172:175], v2, s[12:15], s26 offen offset:1024 nt
    buffer_load_dwordx4 v[176:179], v2, s[12:15], s26 offen offset:2048 nt
    buffer_load_dwordx4 v[180:183], v2, s[12:15], s26 offen offset:3072 nt
    s_add_u32 s25, s25, 32768
    s_add_u32 s26, s25, 4096
    buffer_load_dwordx4 v[184:187], v2, s[12:15], s25 offen offset:0 nt
    buffer_load_dwordx4 v[188:191], v2, s[12:15], s25 offen offset:1024 nt
    buffer_load_dwordx4 v[192:195], v2, s[12:15], s25 offen offset:2048 nt
    buffer_load_dwordx4 v[196:199], v2, s[12:15], s25 offen offset:3072 nt
    buffer_load_dwordx4 v[200:203], v2, s[12:15], s26 offen offset:0 nt
    buffer_load_dwordx4 v[204:207], v2, s[12:15], s26 offen offset:1024 nt
    buffer_load_dwordx4 v[208:211], v2, s[12:15], s26 offen offset:2048 nt
    buffer_load_dwordx4 v[212:215], v2, s[12:15], s26 offen offset:3072 nt
    s_add_u32 s25, s25, 32768
    s_add_u32 s26, s25, 4096
    s_waitcnt lgkmcnt(0)
    s_barrier
    v_lshrrev_b32 v83, 4, v0
    v_lshlrev_b32 v83, 5, v83
    v_add_u32 v83, 139264, v83
    ds_read_b128 v[8:11], v83
    ds_read_b128 v[12:15], v83 offset:16
    v_and_b32 v16, 15, v0
    v_bfe_u32 v17, v0, 4, 2
    v_mul_u32_u24 v18, 528, v16
    v_lshl_add_u32 v18, v17, 7, v18
    s_mul_i32 s3, s24, 34816
    v_add_u32 v18, s3, v18
    v_lshrrev_b32 v17, 4, v0
    v_mul_u32_u24 v19, 528, v17
    v_lshl_add_u32 v19, v16, 5, v19
    v_lshlrev_b32 v17, 4, v0
    s_mov_b32 s50, 0xaaaaaaaa
    s_mov_b32 s51, 0xaaaaaaaa
    s_mov_b32 s52, 0x55555555
    s_mov_b32 s53, 0x55555555
    s_mov_b32 s54, 0xcccccccc
    s_mov_b32 s55, 0xcccccccc
    s_mov_b32 s56, 0x33333333
    s_mov_b32 s57, 0x33333333
    v_add_u32 v16, 69632, v19
    s_waitcnt lgkmcnt(0)
    v_max_f32 v83, v8, v10
    v_max3_f32 v83, v83, v12, v14
    v_sub_f32 v4, v8, v83
    v_sub_f32 v5, v10, v83
    v_sub_f32 v6, v12, v83
    v_sub_f32 v7, v14, v83
    v_exp_f32 v4, v4
    v_exp_f32 v5, v5
    v_exp_f32 v6, v6
    v_exp_f32 v7, v7
    s_nop 0
    v_mul_f32 v83, v4, v9
    v_fmac_f32 v83, v5, v11
    v_fmac_f32 v83, v6, v13
    v_fmac_f32 v83, v7, v15
    v_rcp_f32 v83, v83
    s_nop 0
    v_mul_f32 v4, v4, v83
    v_mul_f32 v5, v5, v83
    v_mul_f32 v6, v6, v83
    v_mul_f32 v7, v7, v83
    ds_read_b32 v82, v85 offset:1088
    ds_read_b128 v[60:63], v3 offset:1088
    s_waitcnt lgkmcnt(0)
    v_mul_f32 v20, v20, v82
    v_mul_f32 v21, v21, v82
    v_mul_f32 v22, v22, v82
    v_mul_f32 v23, v23, v82
    v_mul_f32 v24, v24, v82
    v_mul_f32 v25, v25, v82
    v_mul_f32 v26, v26, v82
    v_mul_f32 v27, v27, v82
    v_mul_f32 v28, v28, v82
    v_mul_f32 v29, v29, v82
    v_mul_f32 v30, v30, v82
    v_mul_f32 v31, v31, v82
    v_mul_f32 v32, v32, v82
    v_mul_f32 v33, v33, v82
    v_mul_f32 v34, v34, v82
    v_mul_f32 v35, v35, v82
    v_mul_f32 v36, v36, v82
    v_mul_f32 v37, v37, v82
    v_mul_f32 v38, v38, v82
    v_mul_f32 v39, v39, v82
    v_mul_f32 v40, v40, v82
    v_mul_f32 v41, v41, v82
    v_mul_f32 v42, v42, v82
    v_mul_f32 v43, v43, v82
    v_mul_f32 v44, v44, v82
    v_mul_f32 v45, v45, v82
    v_mul_f32 v46, v46, v82
    v_mul_f32 v47, v47, v82
    v_mul_f32 v48, v48, v82
    v_mul_f32 v49, v49, v82
    v_mul_f32 v50, v50, v82
    v_mul_f32 v51, v51, v82
    s_waitcnt vmcnt(24)
    v_perm_b32 v64, v124, v120, s29
    v_perm_b32 v65, v132, v128, s29
    v_perm_b32 v66, v140, v136, s29
    v_perm_b32 v67, v148, v144, s29
    v_perm_b32 v68, v124, v120, s30
    v_perm_b32 v69, v132, v128, s30
    v_perm_b32 v70, v140, v136, s30
    v_perm_b32 v71, v148, v144, s30
    v_mfma_f32_16x16x32_bf16 v[20:23], v[64:67], v[60:63], v[20:23]
    v_perm_b32 v72, v125, v121, s29
    v_perm_b32 v73, v133, v129, s29
    v_perm_b32 v74, v141, v137, s29
    v_perm_b32 v75, v149, v145, s29
    v_mfma_f32_16x16x32_bf16 v[24:27], v[68:71], v[60:63], v[24:27]
    v_perm_b32 v76, v125, v121, s30
    v_perm_b32 v77, v133, v129, s30
    v_perm_b32 v78, v141, v137, s30
    v_perm_b32 v79, v149, v145, s30
    v_mfma_f32_16x16x32_bf16 v[28:31], v[72:75], v[60:63], v[28:31]
    v_perm_b32 v64, v126, v122, s29
    v_perm_b32 v65, v134, v130, s29
    v_perm_b32 v66, v142, v138, s29
    v_perm_b32 v67, v150, v146, s29
    v_mfma_f32_16x16x32_bf16 v[32:35], v[76:79], v[60:63], v[32:35]
    v_perm_b32 v68, v126, v122, s30
    v_perm_b32 v69, v134, v130, s30
    v_perm_b32 v70, v142, v138, s30
    v_perm_b32 v71, v150, v146, s30
    v_mfma_f32_16x16x32_bf16 v[36:39], v[64:67], v[60:63], v[36:39]
    v_perm_b32 v72, v127, v123, s29
    v_perm_b32 v73, v135, v131, s29
    v_perm_b32 v74, v143, v139, s29
    v_perm_b32 v75, v151, v147, s29
    v_mfma_f32_16x16x32_bf16 v[40:43], v[68:71], v[60:63], v[40:43]
    v_perm_b32 v76, v127, v123, s30
    v_perm_b32 v77, v135, v131, s30
    v_perm_b32 v78, v143, v139, s30
    v_perm_b32 v79, v151, v147, s30
    v_mfma_f32_16x16x32_bf16 v[44:47], v[72:75], v[60:63], v[44:47]
    s_nop 1
    v_mfma_f32_16x16x32_bf16 v[48:51], v[76:79], v[60:63], v[48:51]
    buffer_load_dwordx4 v[120:123], v2, s[12:15], s25 offen offset:0 nt
    buffer_load_dwordx4 v[124:127], v2, s[12:15], s25 offen offset:1024 nt
    buffer_load_dwordx4 v[128:131], v2, s[12:15], s25 offen offset:2048 nt
    buffer_load_dwordx4 v[132:135], v2, s[12:15], s25 offen offset:3072 nt
    buffer_load_dwordx4 v[136:139], v2, s[12:15], s26 offen offset:0 nt
    buffer_load_dwordx4 v[140:143], v2, s[12:15], s26 offen offset:1024 nt
    buffer_load_dwordx4 v[144:147], v2, s[12:15], s26 offen offset:2048 nt
    buffer_load_dwordx4 v[148:151], v2, s[12:15], s26 offen offset:3072 nt
    ds_read_b32 v82, v85 offset:2176
    ds_read_b128 v[60:63], v3 offset:2176
    s_waitcnt lgkmcnt(0)
    v_mul_f32 v20, v20, v82
    v_mul_f32 v21, v21, v82
    v_mul_f32 v22, v22, v82
    v_mul_f32 v23, v23, v82
    v_mul_f32 v24, v24, v82
    v_mul_f32 v25, v25, v82
    v_mul_f32 v26, v26, v82
    v_mul_f32 v27, v27, v82
    v_mul_f32 v28, v28, v82
    v_mul_f32 v29, v29, v82
    v_mul_f32 v30, v30, v82
    v_mul_f32 v31, v31, v82
    v_mul_f32 v32, v32, v82
    v_mul_f32 v33, v33, v82
    v_mul_f32 v34, v34, v82
    v_mul_f32 v35, v35, v82
    v_mul_f32 v36, v36, v82
    v_mul_f32 v37, v37, v82
    v_mul_f32 v38, v38, v82
    v_mul_f32 v39, v39, v82
    v_mul_f32 v40, v40, v82
    v_mul_f32 v41, v41, v82
    v_mul_f32 v42, v42, v82
    v_mul_f32 v43, v43, v82
    v_mul_f32 v44, v44, v82
    v_mul_f32 v45, v45, v82
    v_mul_f32 v46, v46, v82
    v_mul_f32 v47, v47, v82
    v_mul_f32 v48, v48, v82
    v_mul_f32 v49, v49, v82
    v_mul_f32 v50, v50, v82
    v_mul_f32 v51, v51, v82
    s_waitcnt vmcnt(24)
    v_perm_b32 v64, v92, v88, s29
    v_perm_b32 v65, v100, v96, s29
    v_perm_b32 v66, v108, v104, s29
    v_perm_b32 v67, v116, v112, s29
    v_perm_b32 v68, v92, v88, s30
    v_perm_b32 v69, v100, v96, s30
    v_perm_b32 v70, v108, v104, s30
    v_perm_b32 v71, v116, v112, s30
    v_mfma_f32_16x16x32_bf16 v[20:23], v[64:67], v[60:63], v[20:23]
    v_perm_b32 v72, v93, v89, s29
    v_perm_b32 v73, v101, v97, s29
    v_perm_b32 v74, v109, v105, s29
    v_perm_b32 v75, v117, v113, s29
    v_mfma_f32_16x16x32_bf16 v[24:27], v[68:71], v[60:63], v[24:27]
    v_perm_b32 v76, v93, v89, s30
    v_perm_b32 v77, v101, v97, s30
    v_perm_b32 v78, v109, v105, s30
    v_perm_b32 v79, v117, v113, s30
    v_mfma_f32_16x16x32_bf16 v[28:31], v[72:75], v[60:63], v[28:31]
    v_perm_b32 v64, v94, v90, s29
    v_perm_b32 v65, v102, v98, s29
    v_perm_b32 v66, v110, v106, s29
    v_perm_b32 v67, v118, v114, s29
    v_mfma_f32_16x16x32_bf16 v[32:35], v[76:79], v[60:63], v[32:35]
    v_perm_b32 v68, v94, v90, s30
    v_perm_b32 v69, v102, v98, s30
    v_perm_b32 v70, v110, v106, s30
    v_perm_b32 v71, v118, v114, s30
    v_mfma_f32_16x16x32_bf16 v[36:39], v[64:67], v[60:63], v[36:39]
    v_perm_b32 v72, v95, v91, s29
    v_perm_b32 v73, v103, v99, s29
    v_perm_b32 v74, v111, v107, s29
    v_perm_b32 v75, v119, v115, s29
    v_mfma_f32_16x16x32_bf16 v[40:43], v[68:71], v[60:63], v[40:43]
    v_perm_b32 v76, v95, v91, s30
    v_perm_b32 v77, v103, v99, s30
    v_perm_b32 v78, v111, v107, s30
    v_perm_b32 v79, v119, v115, s30
    v_mfma_f32_16x16x32_bf16 v[44:47], v[72:75], v[60:63], v[44:47]
    s_nop 1
    v_mfma_f32_16x16x32_bf16 v[48:51], v[76:79], v[60:63], v[48:51]
    ds_read_b32 v82, v85 offset:3264
    ds_read_b128 v[60:63], v3 offset:3264
    s_waitcnt lgkmcnt(0)
    v_mul_f32 v20, v20, v82
    v_mul_f32 v21, v21, v82
    v_mul_f32 v22, v22, v82
    v_mul_f32 v23, v23, v82
    v_mul_f32 v24, v24, v82
    v_mul_f32 v25, v25, v82
    v_mul_f32 v26, v26, v82
    v_mul_f32 v27, v27, v82
    v_mul_f32 v28, v28, v82
    v_mul_f32 v29, v29, v82
    v_mul_f32 v30, v30, v82
    v_mul_f32 v31, v31, v82
    v_mul_f32 v32, v32, v82
    v_mul_f32 v33, v33, v82
    v_mul_f32 v34, v34, v82
    v_mul_f32 v35, v35, v82
    v_mul_f32 v36, v36, v82
    v_mul_f32 v37, v37, v82
    v_mul_f32 v38, v38, v82
    v_mul_f32 v39, v39, v82
    v_mul_f32 v40, v40, v82
    v_mul_f32 v41, v41, v82
    v_mul_f32 v42, v42, v82
    v_mul_f32 v43, v43, v82
    v_mul_f32 v44, v44, v82
    v_mul_f32 v45, v45, v82
    v_mul_f32 v46, v46, v82
    v_mul_f32 v47, v47, v82
    v_mul_f32 v48, v48, v82
    v_mul_f32 v49, v49, v82
    v_mul_f32 v50, v50, v82
    v_mul_f32 v51, v51, v82
    s_waitcnt vmcnt(16)
    v_perm_b32 v64, v156, v152, s29
    v_perm_b32 v65, v164, v160, s29
    v_perm_b32 v66, v172, v168, s29
    v_perm_b32 v67, v180, v176, s29
    v_perm_b32 v68, v156, v152, s30
    v_perm_b32 v69, v164, v160, s30
    v_perm_b32 v70, v172, v168, s30
    v_perm_b32 v71, v180, v176, s30
    v_mfma_f32_16x16x32_bf16 v[20:23], v[64:67], v[60:63], v[20:23]
    v_perm_b32 v72, v157, v153, s29
    v_perm_b32 v73, v165, v161, s29
    v_perm_b32 v74, v173, v169, s29
    v_perm_b32 v75, v181, v177, s29
    v_mfma_f32_16x16x32_bf16 v[24:27], v[68:71], v[60:63], v[24:27]
    v_perm_b32 v76, v157, v153, s30
    v_perm_b32 v77, v165, v161, s30
    v_perm_b32 v78, v173, v169, s30
    v_perm_b32 v79, v181, v177, s30
    v_mfma_f32_16x16x32_bf16 v[28:31], v[72:75], v[60:63], v[28:31]
    v_perm_b32 v64, v158, v154, s29
    v_perm_b32 v65, v166, v162, s29
    v_perm_b32 v66, v174, v170, s29
    v_perm_b32 v67, v182, v178, s29
    v_mfma_f32_16x16x32_bf16 v[32:35], v[76:79], v[60:63], v[32:35]
    v_perm_b32 v68, v158, v154, s30
    v_perm_b32 v69, v166, v162, s30
    v_perm_b32 v70, v174, v170, s30
    v_perm_b32 v71, v182, v178, s30
    v_mfma_f32_16x16x32_bf16 v[36:39], v[64:67], v[60:63], v[36:39]
    v_perm_b32 v72, v159, v155, s29
    v_perm_b32 v73, v167, v163, s29
    v_perm_b32 v74, v175, v171, s29
    v_perm_b32 v75, v183, v179, s29
    v_mfma_f32_16x16x32_bf16 v[40:43], v[68:71], v[60:63], v[40:43]
    v_perm_b32 v76, v159, v155, s30
    v_perm_b32 v77, v167, v163, s30
    v_perm_b32 v78, v175, v171, s30
    v_perm_b32 v79, v183, v179, s30
    v_mfma_f32_16x16x32_bf16 v[44:47], v[72:75], v[60:63], v[44:47]
    s_nop 1
    v_mfma_f32_16x16x32_bf16 v[48:51], v[76:79], v[60:63], v[48:51]
    ds_read_b32 v82, v85 offset:4352
    ds_read_b128 v[60:63], v3 offset:4352
    s_waitcnt lgkmcnt(0)
    v_mul_f32 v20, v20, v82
    v_mul_f32 v21, v21, v82
    v_mul_f32 v22, v22, v82
    v_mul_f32 v23, v23, v82
    v_mul_f32 v24, v24, v82
    v_mul_f32 v25, v25, v82
    v_mul_f32 v26, v26, v82
    v_mul_f32 v27, v27, v82
    v_mul_f32 v28, v28, v82
    v_mul_f32 v29, v29, v82
    v_mul_f32 v30, v30, v82
    v_mul_f32 v31, v31, v82
    v_mul_f32 v32, v32, v82
    v_mul_f32 v33, v33, v82
    v_mul_f32 v34, v34, v82
    v_mul_f32 v35, v35, v82
    v_mul_f32 v36, v36, v82
    v_mul_f32 v37, v37, v82
    v_mul_f32 v38, v38, v82
    v_mul_f32 v39, v39, v82
    v_mul_f32 v40, v40, v82
    v_mul_f32 v41, v41, v82
    v_mul_f32 v42, v42, v82
    v_mul_f32 v43, v43, v82
    v_mul_f32 v44, v44, v82
    v_mul_f32 v45, v45, v82
    v_mul_f32 v46, v46, v82
    v_mul_f32 v47, v47, v82
    v_mul_f32 v48, v48, v82
    v_mul_f32 v49, v49, v82
    v_mul_f32 v50, v50, v82
    v_mul_f32 v51, v51, v82
    s_waitcnt vmcnt(8)
    v_perm_b32 v64, v188, v184, s29
    v_perm_b32 v65, v196, v192, s29
    v_perm_b32 v66, v204, v200, s29
    v_perm_b32 v67, v212, v208, s29
    v_perm_b32 v68, v188, v184, s30
    v_perm_b32 v69, v196, v192, s30
    v_perm_b32 v70, v204, v200, s30
    v_perm_b32 v71, v212, v208, s30
    v_mfma_f32_16x16x32_bf16 v[20:23], v[64:67], v[60:63], v[20:23]
    v_perm_b32 v72, v189, v185, s29
    v_perm_b32 v73, v197, v193, s29
    v_perm_b32 v74, v205, v201, s29
    v_perm_b32 v75, v213, v209, s29
    v_mfma_f32_16x16x32_bf16 v[24:27], v[68:71], v[60:63], v[24:27]
    v_perm_b32 v76, v189, v185, s30
    v_perm_b32 v77, v197, v193, s30
    v_perm_b32 v78, v205, v201, s30
    v_perm_b32 v79, v213, v209, s30
    v_mfma_f32_16x16x32_bf16 v[28:31], v[72:75], v[60:63], v[28:31]
    v_perm_b32 v64, v190, v186, s29
    v_perm_b32 v65, v198, v194, s29
    v_perm_b32 v66, v206, v202, s29
    v_perm_b32 v67, v214, v210, s29
    v_mfma_f32_16x16x32_bf16 v[32:35], v[76:79], v[60:63], v[32:35]
    v_perm_b32 v68, v190, v186, s30
    v_perm_b32 v69, v198, v194, s30
    v_perm_b32 v70, v206, v202, s30
    v_perm_b32 v71, v214, v210, s30
    v_mfma_f32_16x16x32_bf16 v[36:39], v[64:67], v[60:63], v[36:39]
    v_perm_b32 v72, v191, v187, s29
    v_perm_b32 v73, v199, v195, s29
    v_perm_b32 v74, v207, v203, s29
    v_perm_b32 v75, v215, v211, s29
    v_mfma_f32_16x16x32_bf16 v[40:43], v[68:71], v[60:63], v[40:43]
    v_perm_b32 v76, v191, v187, s30
    v_perm_b32 v77, v199, v195, s30
    v_perm_b32 v78, v207, v203, s30
    v_perm_b32 v79, v215, v211, s30
    v_mfma_f32_16x16x32_bf16 v[44:47], v[72:75], v[60:63], v[44:47]
    s_nop 1
    v_mfma_f32_16x16x32_bf16 v[48:51], v[76:79], v[60:63], v[48:51]
    ds_read_b32 v82, v85 offset:5440
    ds_read_b128 v[60:63], v3 offset:5440
    s_waitcnt lgkmcnt(0)
    v_mul_f32 v20, v20, v82
    v_mul_f32 v21, v21, v82
    v_mul_f32 v22, v22, v82
    v_mul_f32 v23, v23, v82
    v_mul_f32 v24, v24, v82
    v_mul_f32 v25, v25, v82
    v_mul_f32 v26, v26, v82
    v_mul_f32 v27, v27, v82
    v_mul_f32 v28, v28, v82
    v_mul_f32 v29, v29, v82
    v_mul_f32 v30, v30, v82
    v_mul_f32 v31, v31, v82
    v_mul_f32 v32, v32, v82
    v_mul_f32 v33, v33, v82
    v_mul_f32 v34, v34, v82
    v_mul_f32 v35, v35, v82
    v_mul_f32 v36, v36, v82
    v_mul_f32 v37, v37, v82
    v_mul_f32 v38, v38, v82
    v_mul_f32 v39, v39, v82
    v_mul_f32 v40, v40, v82
    v_mul_f32 v41, v41, v82
    v_mul_f32 v42, v42, v82
    v_mul_f32 v43, v43, v82
    v_mul_f32 v44, v44, v82
    v_mul_f32 v45, v45, v82
    v_mul_f32 v46, v46, v82
    v_mul_f32 v47, v47, v82
    v_mul_f32 v48, v48, v82
    v_mul_f32 v49, v49, v82
    v_mul_f32 v50, v50, v82
    v_mul_f32 v51, v51, v82
    s_waitcnt vmcnt(0)
    v_perm_b32 v64, v124, v120, s29
    v_perm_b32 v65, v132, v128, s29
    v_perm_b32 v66, v140, v136, s29
    v_perm_b32 v67, v148, v144, s29
    v_perm_b32 v68, v124, v120, s30
    v_perm_b32 v69, v132, v128, s30
    v_perm_b32 v70, v140, v136, s30
    v_perm_b32 v71, v148, v144, s30
    v_mfma_f32_16x16x32_bf16 v[20:23], v[64:67], v[60:63], v[20:23]
    v_perm_b32 v72, v125, v121, s29
    v_perm_b32 v73, v133, v129, s29
    v_perm_b32 v74, v141, v137, s29
    v_perm_b32 v75, v149, v145, s29
    v_mfma_f32_16x16x32_bf16 v[24:27], v[68:71], v[60:63], v[24:27]
    v_perm_b32 v76, v125, v121, s30
    v_perm_b32 v77, v133, v129, s30
    v_perm_b32 v78, v141, v137, s30
    v_perm_b32 v79, v149, v145, s30
    v_mfma_f32_16x16x32_bf16 v[28:31], v[72:75], v[60:63], v[28:31]
    ds_write_b128 v18, v[20:23] offset:0
    v_perm_b32 v64, v126, v122, s29
    v_perm_b32 v65, v134, v130, s29
    v_perm_b32 v66, v142, v138, s29
    v_perm_b32 v67, v150, v146, s29
    v_mfma_f32_16x16x32_bf16 v[32:35], v[76:79], v[60:63], v[32:35]
    ds_write_b128 v18, v[24:27] offset:16
    v_perm_b32 v68, v126, v122, s30
    v_perm_b32 v69, v134, v130, s30
    v_perm_b32 v70, v142, v138, s30
    v_perm_b32 v71, v150, v146, s30
    v_mfma_f32_16x16x32_bf16 v[36:39], v[64:67], v[60:63], v[36:39]
    ds_write_b128 v18, v[28:31] offset:32
    v_perm_b32 v72, v127, v123, s29
    v_perm_b32 v73, v135, v131, s29
    v_perm_b32 v74, v143, v139, s29
    v_perm_b32 v75, v151, v147, s29
    v_mfma_f32_16x16x32_bf16 v[40:43], v[68:71], v[60:63], v[40:43]
    ds_write_b128 v18, v[32:35] offset:48
    v_perm_b32 v76, v127, v123, s30
    v_perm_b32 v77, v135, v131, s30
    v_perm_b32 v78, v143, v139, s30
    v_perm_b32 v79, v151, v147, s30
    v_mfma_f32_16x16x32_bf16 v[44:47], v[72:75], v[60:63], v[44:47]
    ds_write_b128 v18, v[36:39] offset:64
    s_nop 1
    v_mfma_f32_16x16x32_bf16 v[48:51], v[76:79], v[60:63], v[48:51]
    ds_write_b128 v18, v[40:43] offset:80
    s_nop 3
    ds_write_b128 v18, v[44:47] offset:96
    s_nop 1
    ds_write_b128 v18, v[48:51] offset:112
    s_waitcnt lgkmcnt(0)
    s_barrier
    ds_read_b128 v[88:91], v19 offset:0
    ds_read_b128 v[92:95], v19 offset:16
    ds_read_b128 v[96:99], v19 offset:34816
    ds_read_b128 v[100:103], v19 offset:34832
    ds_read_b128 v[104:107], v16 offset:0
    ds_read_b128 v[108:111], v16 offset:16
    ds_read_b128 v[112:115], v16 offset:34816
    ds_read_b128 v[116:119], v16 offset:34832
    s_waitcnt lgkmcnt(6)
    v_mul_f32 v20, v88, v4
    v_mul_f32 v21, v89, v4
    v_mul_f32 v22, v90, v4
    v_mul_f32 v23, v91, v4
    v_mul_f32 v24, v92, v4
    v_mul_f32 v25, v93, v4
    v_mul_f32 v26, v94, v4
    v_mul_f32 v27, v95, v4
    s_waitcnt lgkmcnt(4)
    v_fmac_f32 v20, v96, v5
    v_fmac_f32 v21, v97, v5
    v_fmac_f32 v22, v98, v5
    v_fmac_f32 v23, v99, v5
    v_fmac_f32 v24, v100, v5
    v_fmac_f32 v25, v101, v5
    v_fmac_f32 v26, v102, v5
    v_fmac_f32 v27, v103, v5
    s_waitcnt lgkmcnt(2)
    v_fmac_f32 v20, v104, v6
    v_fmac_f32 v21, v105, v6
    v_fmac_f32 v22, v106, v6
    v_fmac_f32 v23, v107, v6
    v_fmac_f32 v24, v108, v6
    v_fmac_f32 v25, v109, v6
    v_fmac_f32 v26, v110, v6
    v_fmac_f32 v27, v111, v6
    s_waitcnt lgkmcnt(0)
    v_fmac_f32 v20, v112, v7
    v_fmac_f32 v21, v113, v7
    v_fmac_f32 v22, v114, v7
    v_fmac_f32 v23, v115, v7
    v_fmac_f32 v24, v116, v7
    v_fmac_f32 v25, v117, v7
    v_fmac_f32 v26, v118, v7
    v_fmac_f32 v27, v119, v7
    v_cvt_pk_bf16_f32 v8, v20, v24
    v_cvt_pk_bf16_f32 v9, v21, v25
    v_cvt_pk_bf16_f32 v10, v22, v26
    v_cvt_pk_bf16_f32 v11, v23, v27
    s_mov_b64 vcc, s[52:53]
    s_nop 0
    v_cndmask_b32_dpp v12, v9, v8, vcc quad_perm:[1,0,3,2] row_mask:0xf bank_mask:0xf
    v_cndmask_b32_dpp v14, v11, v10, vcc quad_perm:[1,0,3,2] row_mask:0xf bank_mask:0xf
    s_mov_b64 vcc, s[50:51]
    v_cndmask_b32_dpp v13, v8, v9, vcc quad_perm:[1,0,3,2] row_mask:0xf bank_mask:0xf
    v_cndmask_b32_dpp v15, v10, v11, vcc quad_perm:[1,0,3,2] row_mask:0xf bank_mask:0xf
    s_mov_b64 vcc, s[56:57]
    s_nop 0
    v_cndmask_b32_dpp v8, v14, v12, vcc quad_perm:[2,3,0,1] row_mask:0xf bank_mask:0xf
    v_cndmask_b32_dpp v9, v15, v13, vcc quad_perm:[2,3,0,1] row_mask:0xf bank_mask:0xf
    s_mov_b64 vcc, s[54:55]
    v_cndmask_b32_dpp v10, v12, v14, vcc quad_perm:[2,3,0,1] row_mask:0xf bank_mask:0xf
    v_cndmask_b32_dpp v11, v13, v15, vcc quad_perm:[2,3,0,1] row_mask:0xf bank_mask:0xf
    buffer_store_dwordx4 v[8:11], v17, s[20:23], 0 offen
L_end:
    s_endpgm
.section .rodata,"a"
.p2align 6
.amdhsa_kernel standalone__gqa_softmax__sampling_kernel
  .amdhsa_next_free_vgpr 216
  .amdhsa_next_free_sgpr 64
  .amdhsa_accum_offset 216
  .amdhsa_group_segment_fixed_size 0
  .amdhsa_kernarg_size 48
  .amdhsa_user_sgpr_count 2
  .amdhsa_user_sgpr_kernarg_segment_ptr 1
  .amdhsa_system_sgpr_workgroup_id_x 1
.end_amdhsa_kernel
```
